```python
import torch

def _softmax(x, axis=-1):
    return torch.softmax(x, dim=axis)
def _gelu(x):
    return torch.nn.functional.gelu(x, approximate="tanh")
def _silu(x):
    return torch.nn.functional.silu(x)
def _sigmoid(x):
    return torch.sigmoid(x)
def _layernorm(x, axis=-1, eps=1e-5):
    m = x.mean(dim=axis, keepdim=True)
    v = x.var(dim=axis, keepdim=True, unbiased=False)
    return (x - m) / torch.sqrt(v + eps)
def _scatter_add(tgt, idx, src, axis=0):
    return tgt.clone().index_add_(axis, idx, src)
def _segment_sum(src, seg, n):
    out = torch.zeros((n,) + src.shape[1:], dtype=src.dtype)
    return out.index_add_(0, seg, src)
def _pad(x, pw):
    flat = tuple(v for pair in reversed(pw) for v in pair)
    return torch.nn.functional.pad(x, flat)

kernel_name = 'standalone__softmax_full_bidir__decode'

def setup_inputs():

    _w = (lambda a: (lambda t: t.to(torch.bfloat16) if t.is_floating_point() else t)(torch.as_tensor(a)))
    B, H, Sq, Skv, Dh = 2, 32, 1, 16384, 128
    return {
        "q": _w((lambda *s: torch.randn(*s, dtype=torch.bfloat16) * 0.8)(B, H, Sq, Dh)),
        "k": _w((lambda *s: torch.randn(*s, dtype=torch.bfloat16) * 0.8)(B, H, Skv, Dh)),
        "v": _w((lambda *s: torch.randn(*s, dtype=torch.bfloat16) * 0.05)(B, H, Skv, Dh)),
    }

def reference(q, k, v):
    scale = q.shape[-1] ** -0.5
    scores = torch.einsum('bhqd,bhkd->bhqk', q, k) * scale
    attn = _softmax(scores, axis=-1)
    return torch.einsum('bhqk,bhkd->bhqd', attn, v)
```

```asm
; @launch grid=(256,1,1) block=(192,1,1) lds=16448
.amdgcn_target "amdgcn-amd-amdhsa--gfx950"
.text
.globl standalone__softmax_full_bidir__decode_kernel
.p2align 8
.type standalone__softmax_full_bidir__decode_kernel,@function
standalone__softmax_full_bidir__decode_kernel:
  s_load_dwordx4 s[4:7], s[0:1], 0
  s_load_dwordx4 s[24:27], s[0:1], 16
  s_load_dwordx4 s[44:47], s[0:1], 32
  s_cmp_ge_u32 s2, 256
  s_cbranch_scc1 L_done
  v_lshrrev_b32 v37, 6, v0
  v_and_b32 v1, 63, v0
  v_readfirstlane_b32 s29, v37
  v_lshlrev_b32 v6, 4, v1
  v_and_b32 v35, 15, v0
  v_lshlrev_b32 v36, 4, v35
  s_lshr_b32 s28, s2, 3
  s_lshl_b32 s28, s28, 1
  s_and_b32 s34, s2, 7
  s_cmp_eq_u32 s29, 2
  s_cbranch_scc1 L_helper
  s_add_u32 s28, s28, s29
  s_lshl_b32 s16, s34, 14
  s_lshl_b32 s42, s29, 12
  s_lshl_b32 s30, s28, 22
  s_lshl_b32 s31, s28, 8
  s_movk_i32 s80, 0x2000
  s_xor_b32 s43, s16, s42
  v_add_u32 v2, s43, v6
  v_add_u32 v3, 0x200000, v2
  s_mov_b32 s10, 0x400000
  s_mov_b32 s11, 0x20000
  s_mov_b32 s14, 0x400000
  s_mov_b32 s15, 0x20000
  s_mov_b32 s22, 0x4000
  s_mov_b32 s23, 0x20000
  s_waitcnt lgkmcnt(0)
  s_add_u32 s8, s6, s30
  s_addc_u32 s9, s7, 0
  s_mov_b32 s12, s8
  s_mov_b32 s13, s9
  s_mov_b32 s20, s4
  s_mov_b32 s21, s5
  buffer_load_dwordx4 v[8:11], v36, s[20:23], s31 offen
  buffer_load_dwordx4 v[48:51], v2, s[8:11], 0 offen nt
  buffer_load_dwordx4 v[52:55], v2, s[8:11], s80 offen nt
  buffer_load_dwordx4 v[56:59], v2, s[8:11], 0 offen offset:1024 nt
  buffer_load_dwordx4 v[60:63], v2, s[8:11], s80 offen offset:1024 nt
  buffer_load_dwordx4 v[64:67], v2, s[8:11], 0 offen offset:2048 nt
  buffer_load_dwordx4 v[68:71], v2, s[8:11], s80 offen offset:2048 nt
  buffer_load_dwordx4 v[72:75], v2, s[8:11], 0 offen offset:3072 nt
  buffer_load_dwordx4 v[76:79], v2, s[8:11], s80 offen offset:3072 nt
  buffer_load_dwordx4 v[80:83], v3, s[12:15], 0 offen nt
  buffer_load_dwordx4 v[84:87], v3, s[12:15], s80 offen nt
  buffer_load_dwordx4 v[88:91], v3, s[12:15], 0 offen offset:1024 nt
  buffer_load_dwordx4 v[92:95], v3, s[12:15], s80 offen offset:1024 nt
  buffer_load_dwordx4 v[96:99], v3, s[12:15], 0 offen offset:2048 nt
  buffer_load_dwordx4 v[100:103], v3, s[12:15], s80 offen offset:2048 nt
  buffer_load_dwordx4 v[104:107], v3, s[12:15], 0 offen offset:3072 nt
  buffer_load_dwordx4 v[108:111], v3, s[12:15], s80 offen offset:3072 nt
  s_mov_b32 s76, s8
  s_mov_b32 s77, s9
  s_add_u32 s78, s24, s30
  s_addc_u32 s79, s25, 0
  s_add_u32 s30, s31, 0x100000
  s_add_u32 s36, s46, s30
  s_addc_u32 s37, s47, 0
  s_lshl_b32 s30, s28, 2
  s_add_u32 s40, s44, s30
  s_addc_u32 s41, s45, 0
  v_mov_b32 v121, 16384
  v_mov_b32 v122, 0
  ds_write_b32 v121, v122
  s_lshl_b32 s30, s28, 13
  s_add_u32 s64, s46, s30
  s_addc_u32 s65, s47, 0
  s_mov_b32 s66, 0x2000
  s_mov_b32 s67, 0x20000
  s_mov_b32 s68, s26
  s_mov_b32 s69, s27
  s_mov_b32 s70, 0x4000
  s_mov_b32 s71, 0x20000
  s_mov_b32 s86, 0xff00ff00
  s_mov_b32 s87, 0xff00ff00
  s_mov_b32 s82, 0x01010101
  s_mov_b32 s83, 0x01010101
  s_add_u32 s88, s34, 0
  s_and_b32 s88, s88, 7
  s_lshl_b32 s88, s88, 10
  s_add_u32 s89, s34, 1
  s_and_b32 s89, s89, 7
  s_lshl_b32 s89, s89, 10
  s_add_u32 s90, s34, 2
  s_and_b32 s90, s90, 7
  s_lshl_b32 s90, s90, 10
  s_add_u32 s91, s34, 3
  s_and_b32 s91, s91, 7
  s_lshl_b32 s91, s91, 10
  s_add_u32 s92, s34, 4
  s_and_b32 s92, s92, 7
  s_lshl_b32 s92, s92, 10
  s_add_u32 s93, s34, 5
  s_and_b32 s93, s93, 7
  s_lshl_b32 s93, s93, 10
  s_add_u32 s94, s34, 6
  s_and_b32 s94, s94, 7
  s_lshl_b32 s94, s94, 10
  s_add_u32 s95, s34, 7
  s_and_b32 s95, s95, 7
  s_lshl_b32 s95, s95, 10
  v_lshrrev_b32 v37, 4, v1
  v_lshl_add_u32 v5, v37, 3, v35
  v_lshlrev_b32 v5, 4, v5
  v_mov_b32 v36, 0x200
  v_cndmask_b32 v5, v5, v36, s[86:87]
  v_lshl_add_u32 v120, v37, 5, v35
  v_lshlrev_b32 v120, 1, v120
  v_mov_b32 v36, 0x10000
  v_cndmask_b32 v120, v120, v36, s[86:87]
  v_lshrrev_b32 v4, 3, v1
  v_lshlrev_b32 v4, 4, v4
  s_mul_i32 s30, s29, 8192
  v_add_u32 v4, s30, v4
  v_and_b32 v36, 1, v35
  v_cmp_eq_u32 vcc, 1, v36
  v_mov_b32 v36, 0xffff
  v_mov_b32 v37, 0xffff0000
  v_cndmask_b32 v36, v36, v37, vcc
  v_lshrrev_b32 v35, 1, v35
  v_cmp_eq_u32 vcc, 0, v35
  s_nop 1
  v_cndmask_b32 v12, 0, v36, vcc
  v_cmp_eq_u32 vcc, 1, v35
  s_nop 1
  v_cndmask_b32 v13, 0, v36, vcc
  v_cmp_eq_u32 vcc, 2, v35
  s_nop 1
  v_cndmask_b32 v14, 0, v36, vcc
  v_cmp_eq_u32 vcc, 3, v35
  s_nop 1
  v_cndmask_b32 v15, 0, v36, vcc
  v_cmp_eq_u32 vcc, 4, v35
  s_nop 1
  v_cndmask_b32 v16, 0, v36, vcc
  v_cmp_eq_u32 vcc, 5, v35
  s_nop 1
  v_cndmask_b32 v17, 0, v36, vcc
  v_cmp_eq_u32 vcc, 6, v35
  s_nop 1
  v_cndmask_b32 v18, 0, v36, vcc
  v_cmp_eq_u32 vcc, 7, v35
  s_nop 1
  v_cndmask_b32 v19, 0, v36, vcc
  v_mov_b32 v20, 0
  v_mov_b32 v21, 0
  v_mov_b32 v22, 0
  v_mov_b32 v23, 0
  v_mov_b32 v124, -1
  v_mov_b32 v125, -1
  v_mov_b32 v126, -1
  v_mov_b32 v127, -1
  v_mov_b32 v128, -1
  v_mov_b32 v129, -1
  v_mov_b32 v130, -1
  v_mov_b32 v131, -1
  v_mov_b32 v132, -1
  v_mov_b32 v133, -1
  v_mov_b32 v134, -1
  v_mov_b32 v135, -1
  v_mov_b32 v136, -1
  v_mov_b32 v137, -1
  v_mov_b32 v138, -1
  v_mov_b32 v139, -1
  v_mov_b32 v140, -1
  v_mov_b32 v141, -1
  v_mov_b32 v142, -1
  v_mov_b32 v143, -1
  v_mov_b32 v144, -1
  v_mov_b32 v145, -1
  v_mov_b32 v146, -1
  v_mov_b32 v147, -1
  v_mov_b32 v148, -1
  v_mov_b32 v149, -1
  v_mov_b32 v150, -1
  v_mov_b32 v151, -1
  v_mov_b32 v32, 0
  v_mov_b32 v7, 0xff800000
  v_mov_b32 v34, 0x3f003f00
  s_mov_b32 s17, 0
  s_mov_b32 s18, 0x3e0293ee
  s_mov_b32 s99, 0x10000
  s_mov_b32 s98, 0
  s_waitcnt lgkmcnt(0)
  s_barrier
L_kloop:
  s_bitcmp1_b32 s16, 12
  s_cselect_b32 s43, 31, 1
  s_lshl_b32 s43, s43, 12
  s_add_u32 s16, s16, s43
  s_cmp_eq_u32 s17, 8
  s_cbranch_scc1 L_ev_flagload
  s_cmp_eq_u32 s17, 27
  s_cbranch_scc1 L_ev_klast
L_kbody:
  s_xor_b32 s43, s16, s42
  v_add_u32 v2, s43, v6
  v_add_u32 v3, 0x200000, v2
  s_waitcnt vmcnt(9)
  v_dot2_f32_bf16 v40, v48, v8, 0
  v_dot2_f32_bf16 v40, v49, v9, v40
  v_dot2_f32_bf16 v40, v50, v10, v40
  v_dot2_f32_bf16 v40, v51, v11, v40
  buffer_load_dwordx4 v[48:51], v2, s[8:11], 0 offen nt
  s_waitcnt vmcnt(9)
  v_dot2_f32_bf16 v41, v52, v8, 0
  v_dot2_f32_bf16 v41, v53, v9, v41
  v_dot2_f32_bf16 v41, v54, v10, v41
  v_dot2_f32_bf16 v41, v55, v11, v41
  buffer_load_dwordx4 v[52:55], v2, s[8:11], s80 offen nt
  s_waitcnt vmcnt(9)
  v_dot2_f32_bf16 v42, v56, v8, 0
  v_dot2_f32_bf16 v42, v57, v9, v42
  v_dot2_f32_bf16 v42, v58, v10, v42
  v_dot2_f32_bf16 v42, v59, v11, v42
  buffer_load_dwordx4 v[56:59], v2, s[8:11], 0 offen offset:1024 nt
  s_waitcnt vmcnt(10)
  v_dot2_f32_bf16 v43, v60, v8, 0
  v_dot2_f32_bf16 v43, v61, v9, v43
  v_dot2_f32_bf16 v43, v62, v10, v43
  v_dot2_f32_bf16 v43, v63, v11, v43
  buffer_load_dwordx4 v[60:63], v2, s[8:11], s80 offen offset:1024 nt
  s_waitcnt vmcnt(9)
  v_dot2_f32_bf16 v44, v64, v8, 0
  v_dot2_f32_bf16 v44, v65, v9, v44
  v_dot2_f32_bf16 v44, v66, v10, v44
  v_dot2_f32_bf16 v44, v67, v11, v44
  buffer_load_dwordx4 v[64:67], v2, s[8:11], 0 offen offset:2048 nt
  s_waitcnt vmcnt(9)
  v_dot2_f32_bf16 v45, v68, v8, 0
  v_dot2_f32_bf16 v45, v69, v9, v45
  v_dot2_f32_bf16 v45, v70, v10, v45
  v_dot2_f32_bf16 v45, v71, v11, v45
  buffer_load_dwordx4 v[68:71], v2, s[8:11], s80 offen offset:2048 nt
  s_waitcnt vmcnt(9)
  v_dot2_f32_bf16 v46, v72, v8, 0
  v_dot2_f32_bf16 v46, v73, v9, v46
  v_dot2_f32_bf16 v46, v74, v10, v46
  v_dot2_f32_bf16 v46, v75, v11, v46
  buffer_load_dwordx4 v[72:75], v2, s[8:11], 0 offen offset:3072 nt
  s_waitcnt vmcnt(10)
  v_dot2_f32_bf16 v47, v76, v8, 0
  v_dot2_f32_bf16 v47, v77, v9, v47
  v_dot2_f32_bf16 v47, v78, v10, v47
  v_dot2_f32_bf16 v47, v79, v11, v47
  buffer_load_dwordx4 v[76:79], v2, s[8:11], s80 offen offset:3072 nt
  s_nop 1
  v_add_f32_dpp v112, v40, v40 row_ror:8 row_mask:0xf bank_mask:0x3
  v_add_f32_dpp v113, v42, v42 row_ror:8 row_mask:0xf bank_mask:0x3
  v_add_f32_dpp v114, v44, v44 row_ror:8 row_mask:0xf bank_mask:0x3
  v_add_f32_dpp v115, v46, v46 row_ror:8 row_mask:0xf bank_mask:0x3
  v_add_f32_dpp v112, v41, v41 row_ror:8 row_mask:0xf bank_mask:0xc
  v_add_f32_dpp v113, v43, v43 row_ror:8 row_mask:0xf bank_mask:0xc
  v_add_f32_dpp v114, v45, v45 row_ror:8 row_mask:0xf bank_mask:0xc
  v_add_f32_dpp v115, v47, v47 row_ror:8 row_mask:0xf bank_mask:0xc
  v_add_f32_dpp v112, v112, v112 row_half_mirror row_mask:0xf bank_mask:0xf
  v_add_f32_dpp v113, v113, v113 row_half_mirror row_mask:0xf bank_mask:0xf
  v_add_f32_dpp v114, v114, v114 row_half_mirror row_mask:0xf bank_mask:0xf
  v_add_f32_dpp v115, v115, v115 row_half_mirror row_mask:0xf bank_mask:0xf
  v_add_f32_dpp v112, v112, v112 quad_perm:[1,0,3,2] row_mask:0xf bank_mask:0xf
  v_add_f32_dpp v113, v113, v113 quad_perm:[1,0,3,2] row_mask:0xf bank_mask:0xf
  v_add_f32_dpp v114, v114, v114 quad_perm:[1,0,3,2] row_mask:0xf bank_mask:0xf
  v_add_f32_dpp v115, v115, v115 quad_perm:[1,0,3,2] row_mask:0xf bank_mask:0xf
  v_add_f32_dpp v112, v112, v112 quad_perm:[2,3,0,1] row_mask:0xf bank_mask:0xf
  v_add_f32_dpp v113, v113, v113 quad_perm:[2,3,0,1] row_mask:0xf bank_mask:0xf
  v_add_f32_dpp v114, v114, v114 quad_perm:[2,3,0,1] row_mask:0xf bank_mask:0xf
  v_add_f32_dpp v115, v115, v115 quad_perm:[2,3,0,1] row_mask:0xf bank_mask:0xf
  v_max3_f32 v7, v112, v113, v7
  s_mov_b64 exec, s[82:83]
  ds_write_b128 v4, v[112:115] offset:0
  s_mov_b64 exec, -1
  v_max3_f32 v7, v114, v115, v7
  s_waitcnt vmcnt(9)
  v_dot2_f32_bf16 v40, v80, v8, 0
  v_dot2_f32_bf16 v40, v81, v9, v40
  v_dot2_f32_bf16 v40, v82, v10, v40
  v_dot2_f32_bf16 v40, v83, v11, v40
  buffer_load_dwordx4 v[80:83], v3, s[12:15], 0 offen nt
  s_waitcnt vmcnt(9)
  v_dot2_f32_bf16 v41, v84, v8, 0
  v_dot2_f32_bf16 v41, v85, v9, v41
  v_dot2_f32_bf16 v41, v86, v10, v41
  v_dot2_f32_bf16 v41, v87, v11, v41
  buffer_load_dwordx4 v[84:87], v3, s[12:15], s80 offen nt
  s_waitcnt vmcnt(9)
  v_dot2_f32_bf16 v42, v88, v8, 0
  v_dot2_f32_bf16 v42, v89, v9, v42
  v_dot2_f32_bf16 v42, v90, v10, v42
  v_dot2_f32_bf16 v42, v91, v11, v42
  buffer_load_dwordx4 v[88:91], v3, s[12:15], 0 offen offset:1024 nt
  s_waitcnt vmcnt(10)
  v_dot2_f32_bf16 v43, v92, v8, 0
  v_dot2_f32_bf16 v43, v93, v9, v43
  v_dot2_f32_bf16 v43, v94, v10, v43
  v_dot2_f32_bf16 v43, v95, v11, v43
  buffer_load_dwordx4 v[92:95], v3, s[12:15], s80 offen offset:1024 nt
  s_waitcnt vmcnt(9)
  v_dot2_f32_bf16 v44, v96, v8, 0
  v_dot2_f32_bf16 v44, v97, v9, v44
  v_dot2_f32_bf16 v44, v98, v10, v44
  v_dot2_f32_bf16 v44, v99, v11, v44
  buffer_load_dwordx4 v[96:99], v3, s[12:15], 0 offen offset:2048 nt
  s_waitcnt vmcnt(9)
  v_dot2_f32_bf16 v45, v100, v8, 0
  v_dot2_f32_bf16 v45, v101, v9, v45
  v_dot2_f32_bf16 v45, v102, v10, v45
  v_dot2_f32_bf16 v45, v103, v11, v45
  buffer_load_dwordx4 v[100:103], v3, s[12:15], s80 offen offset:2048 nt
  s_waitcnt vmcnt(9)
  v_dot2_f32_bf16 v46, v104, v8, 0
  v_dot2_f32_bf16 v46, v105, v9, v46
  v_dot2_f32_bf16 v46, v106, v10, v46
  v_dot2_f32_bf16 v46, v107, v11, v46
  buffer_load_dwordx4 v[104:107], v3, s[12:15], 0 offen offset:3072 nt
  s_waitcnt vmcnt(10)
  v_dot2_f32_bf16 v47, v108, v8, 0
  v_dot2_f32_bf16 v47, v109, v9, v47
  v_dot2_f32_bf16 v47, v110, v10, v47
  v_dot2_f32_bf16 v47, v111, v11, v47
  buffer_load_dwordx4 v[108:111], v3, s[12:15], s80 offen offset:3072 nt
  s_nop 1
  v_add_f32_dpp v116, v40, v40 row_ror:8 row_mask:0xf bank_mask:0x3
  v_add_f32_dpp v117, v42, v42 row_ror:8 row_mask:0xf bank_mask:0x3
  v_add_f32_dpp v118, v44, v44 row_ror:8 row_mask:0xf bank_mask:0x3
  v_add_f32_dpp v119, v46, v46 row_ror:8 row_mask:0xf bank_mask:0x3
  v_add_f32_dpp v116, v41, v41 row_ror:8 row_mask:0xf bank_mask:0xc
  v_add_f32_dpp v117, v43, v43 row_ror:8 row_mask:0xf bank_mask:0xc
  v_add_f32_dpp v118, v45, v45 row_ror:8 row_mask:0xf bank_mask:0xc
  v_add_f32_dpp v119, v47, v47 row_ror:8 row_mask:0xf bank_mask:0xc
  v_add_f32_dpp v116, v116, v116 row_half_mirror row_mask:0xf bank_mask:0xf
  v_add_f32_dpp v117, v117, v117 row_half_mirror row_mask:0xf bank_mask:0xf
  v_add_f32_dpp v118, v118, v118 row_half_mirror row_mask:0xf bank_mask:0xf
  v_add_f32_dpp v119, v119, v119 row_half_mirror row_mask:0xf bank_mask:0xf
  v_add_f32_dpp v116, v116, v116 quad_perm:[1,0,3,2] row_mask:0xf bank_mask:0xf
  v_add_f32_dpp v117, v117, v117 quad_perm:[1,0,3,2] row_mask:0xf bank_mask:0xf
  v_add_f32_dpp v118, v118, v118 quad_perm:[1,0,3,2] row_mask:0xf bank_mask:0xf
  v_add_f32_dpp v119, v119, v119 quad_perm:[1,0,3,2] row_mask:0xf bank_mask:0xf
  v_add_f32_dpp v116, v116, v116 quad_perm:[2,3,0,1] row_mask:0xf bank_mask:0xf
  v_add_f32_dpp v117, v117, v117 quad_perm:[2,3,0,1] row_mask:0xf bank_mask:0xf
  v_add_f32_dpp v118, v118, v118 quad_perm:[2,3,0,1] row_mask:0xf bank_mask:0xf
  v_add_f32_dpp v119, v119, v119 quad_perm:[2,3,0,1] row_mask:0xf bank_mask:0xf
  v_max3_f32 v7, v116, v117, v7
  s_mov_b64 exec, s[82:83]
  ds_write_b128 v4, v[116:119] offset:128
  s_mov_b64 exec, -1
  v_max3_f32 v7, v118, v119, v7
  v_add_u32 v4, 0x100, v4
  s_add_u32 s17, s17, 1
  s_cmp_lt_u32 s17, 28
  s_cbranch_scc1 L_kloop
  v_subrev_u32 v4, 7168, v4
  s_waitcnt lgkmcnt(0)
  ds_read_b128 v[112:115], v4
  s_nop 1
  v_max_f32_dpp v7, v7, v7 row_ror:8 row_mask:0xf bank_mask:0xf
  s_nop 1
  v_max_f32_dpp v7, v7, v7 row_bcast:15 row_mask:0xa bank_mask:0xf
  s_nop 1
  v_max_f32_dpp v7, v7, v7 row_bcast:31 row_mask:0xc bank_mask:0xf
  v_mul_f32 v7, s18, v7
  s_nop 0
  v_readlane_b32 s19, v7, 63
  s_mov_b32 s17, 0
  s_nop 0
  v_mov_b32 v33, s19
L_vloop:
  s_bitcmp1_b32 s16, 12
  s_cselect_b32 s43, 31, 1
  s_lshl_b32 s43, s43, 12
  s_add_u32 s16, s16, s43
  s_cmp_eq_u32 s17, 27
  s_cbranch_scc1 L_ev_vlast
  s_xor_b32 s43, s16, s42
  v_add_u32 v2, s43, v6
  v_add_u32 v3, 0x200000, v2
L_vbody:
  s_waitcnt lgkmcnt(0)
  ds_read_b128 v[116:119], v4 offset:128
  v_fma_f32 v112, v112, s18, -v33
  v_fma_f32 v113, v113, s18, -v33
  v_fma_f32 v114, v114, s18, -v33
  v_fma_f32 v115, v115, s18, -v33
  v_exp_f32 v112, v112
  v_exp_f32 v113, v113
  v_exp_f32 v114, v114
  v_exp_f32 v115, v115
  v_cvt_pk_bf16_f32 v112, v112, v112
  v_cvt_pk_bf16_f32 v113, v113, v113
  v_cvt_pk_bf16_f32 v114, v114, v114
  v_cvt_pk_bf16_f32 v115, v115, v115
  v_dot2_f32_bf16 v32, v112, v34, v32
  v_dot2_f32_bf16 v32, v113, v34, v32
  v_dot2_f32_bf16 v32, v114, v34, v32
  v_dot2_f32_bf16 v32, v115, v34, v32
  v_and_b32 v24, v112, v12
  v_and_b32 v25, v112, v13
  v_and_b32 v26, v112, v14
  v_and_b32 v27, v112, v15
  v_and_b32 v28, v112, v16
  v_and_b32 v29, v112, v17
  v_and_b32 v30, v112, v18
  v_and_b32 v31, v112, v19
  s_waitcnt vmcnt(9)
  v_mfma_f32_16x16x32_bf16 v[20:23], v[48:51], v[24:27], v[20:23]
  buffer_load_dwordx4 v[48:51], v2, s[8:11], 0 offen nt
  v_and_b32 v24, v113, v12
  v_and_b32 v25, v113, v13
  v_and_b32 v26, v113, v14
  v_and_b32 v27, v113, v15
  s_waitcnt vmcnt(9)
  v_mfma_f32_16x16x32_bf16 v[20:23], v[52:55], v[28:31], v[20:23]
  buffer_load_dwordx4 v[52:55], v2, s[8:11], s80 offen nt
  v_and_b32 v28, v113, v16
  v_and_b32 v29, v113, v17
  v_and_b32 v30, v113, v18
  v_and_b32 v31, v113, v19
  s_waitcnt vmcnt(9)
  v_mfma_f32_16x16x32_bf16 v[20:23], v[56:59], v[24:27], v[20:23]
  buffer_load_dwordx4 v[56:59], v2, s[8:11], 0 offen offset:1024 nt
  v_and_b32 v24, v114, v12
  v_and_b32 v25, v114, v13
  v_and_b32 v26, v114, v14
  v_and_b32 v27, v114, v15
  s_waitcnt vmcnt(10)
  v_mfma_f32_16x16x32_bf16 v[20:23], v[60:63], v[28:31], v[20:23]
  buffer_load_dwordx4 v[60:63], v2, s[8:11], s80 offen offset:1024 nt
  v_and_b32 v28, v114, v16
  v_and_b32 v29, v114, v17
  v_and_b32 v30, v114, v18
  v_and_b32 v31, v114, v19
  s_waitcnt vmcnt(9)
  v_mfma_f32_16x16x32_bf16 v[20:23], v[64:67], v[24:27], v[20:23]
  buffer_load_dwordx4 v[64:67], v2, s[8:11], 0 offen offset:2048 nt
  v_and_b32 v24, v115, v12
  v_and_b32 v25, v115, v13
  v_and_b32 v26, v115, v14
  v_and_b32 v27, v115, v15
  s_waitcnt vmcnt(9)
  v_mfma_f32_16x16x32_bf16 v[20:23], v[68:71], v[28:31], v[20:23]
  buffer_load_dwordx4 v[68:71], v2, s[8:11], s80 offen offset:2048 nt
  v_and_b32 v28, v115, v16
  v_and_b32 v29, v115, v17
  v_and_b32 v30, v115, v18
  v_and_b32 v31, v115, v19
  s_waitcnt vmcnt(9)
  v_mfma_f32_16x16x32_bf16 v[20:23], v[72:75], v[24:27], v[20:23]
  buffer_load_dwordx4 v[72:75], v2, s[8:11], 0 offen offset:3072 nt
  s_nop 1
  s_waitcnt vmcnt(10)
  v_mfma_f32_16x16x32_bf16 v[20:23], v[76:79], v[28:31], v[20:23]
  buffer_load_dwordx4 v[76:79], v2, s[8:11], s80 offen offset:3072 nt
  s_waitcnt lgkmcnt(0)
  ds_read_b128 v[112:115], v4 offset:256
  v_fma_f32 v116, v116, s18, -v33
  v_fma_f32 v117, v117, s18, -v33
  v_fma_f32 v118, v118, s18, -v33
  v_fma_f32 v119, v119, s18, -v33
  v_exp_f32 v116, v116
  v_exp_f32 v117, v117
  v_exp_f32 v118, v118
  v_exp_f32 v119, v119
  v_cvt_pk_bf16_f32 v116, v116, v116
  v_cvt_pk_bf16_f32 v117, v117, v117
  v_cvt_pk_bf16_f32 v118, v118, v118
  v_cvt_pk_bf16_f32 v119, v119, v119
  v_dot2_f32_bf16 v32, v116, v34, v32
  v_dot2_f32_bf16 v32, v117, v34, v32
  v_dot2_f32_bf16 v32, v118, v34, v32
  v_dot2_f32_bf16 v32, v119, v34, v32
  v_and_b32 v24, v116, v12
  v_and_b32 v25, v116, v13
  v_and_b32 v26, v116, v14
  v_and_b32 v27, v116, v15
  v_and_b32 v28, v116, v16
  v_and_b32 v29, v116, v17
  v_and_b32 v30, v116, v18
  v_and_b32 v31, v116, v19
  s_waitcnt vmcnt(9)
  v_mfma_f32_16x16x32_bf16 v[20:23], v[80:83], v[24:27], v[20:23]
  buffer_load_dwordx4 v[80:83], v3, s[12:15], 0 offen nt
  v_and_b32 v24, v117, v12
  v_and_b32 v25, v117, v13
  v_and_b32 v26, v117, v14
  v_and_b32 v27, v117, v15
  s_waitcnt vmcnt(9)
  v_mfma_f32_16x16x32_bf16 v[20:23], v[84:87], v[28:31], v[20:23]
  buffer_load_dwordx4 v[84:87], v3, s[12:15], s80 offen nt
  v_and_b32 v28, v117, v16
  v_and_b32 v29, v117, v17
  v_and_b32 v30, v117, v18
  v_and_b32 v31, v117, v19
  s_waitcnt vmcnt(9)
  v_mfma_f32_16x16x32_bf16 v[20:23], v[88:91], v[24:27], v[20:23]
  buffer_load_dwordx4 v[88:91], v3, s[12:15], 0 offen offset:1024 nt
  v_and_b32 v24, v118, v12
  v_and_b32 v25, v118, v13
  v_and_b32 v26, v118, v14
  v_and_b32 v27, v118, v15
  s_waitcnt vmcnt(10)
  v_mfma_f32_16x16x32_bf16 v[20:23], v[92:95], v[28:31], v[20:23]
  buffer_load_dwordx4 v[92:95], v3, s[12:15], s80 offen offset:1024 nt
  v_and_b32 v28, v118, v16
  v_and_b32 v29, v118, v17
  v_and_b32 v30, v118, v18
  v_and_b32 v31, v118, v19
  s_waitcnt vmcnt(9)
  v_mfma_f32_16x16x32_bf16 v[20:23], v[96:99], v[24:27], v[20:23]
  buffer_load_dwordx4 v[96:99], v3, s[12:15], 0 offen offset:2048 nt
  v_and_b32 v24, v119, v12
  v_and_b32 v25, v119, v13
  v_and_b32 v26, v119, v14
  v_and_b32 v27, v119, v15
  s_waitcnt vmcnt(9)
  v_mfma_f32_16x16x32_bf16 v[20:23], v[100:103], v[28:31], v[20:23]
  buffer_load_dwordx4 v[100:103], v3, s[12:15], s80 offen offset:2048 nt
  v_and_b32 v28, v119, v16
  v_and_b32 v29, v119, v17
  v_and_b32 v30, v119, v18
  v_and_b32 v31, v119, v19
  s_waitcnt vmcnt(9)
  v_mfma_f32_16x16x32_bf16 v[20:23], v[104:107], v[24:27], v[20:23]
  buffer_load_dwordx4 v[104:107], v3, s[12:15], 0 offen offset:3072 nt
  s_nop 1
  s_waitcnt vmcnt(10)
  v_mfma_f32_16x16x32_bf16 v[20:23], v[108:111], v[28:31], v[20:23]
  buffer_load_dwordx4 v[108:111], v3, s[12:15], s80 offen offset:3072 nt
  v_add_u32 v4, 0x100, v4
  s_add_u32 s17, s17, 1
  s_cmp_lt_u32 s17, 28
  s_cbranch_scc1 L_vloop
  s_waitcnt lgkmcnt(0)
L_dyn:
  s_cmp_eq_u32 s73, 0
  s_cbranch_scc1 L_newgrab
  s_sub_u32 s73, s73, 1
  s_add_u32 s19, s74, 1
  s_branch L_haveidx
L_newgrab:
  s_waitcnt lgkmcnt(0)
  s_add_u32 s98, s35, s97
  s_lshr_b32 s98, s98, 16
  s_and_b32 s19, s35, 0xffff
  s_add_u32 s19, s19, 464
  s_mov_b32 s96, s19
  s_sub_u32 s73, s75, 1
L_haveidx:
  s_min_u32 s19, s19, 512
  s_mov_b32 s74, s19
  s_sub_u32 s48, s19, 448
  s_and_b32 s49, s48, 1
  s_lshl_b32 s49, s49, 21
  s_lshr_b32 s43, s48, 2
  s_lshl_b32 s43, s43, 14
  s_or_b32 s43, s43, s49
  s_bfe_u32 s49, s48, 0x10001
  s_lshl_b32 s49, s49, 12
  s_or_b32 s43, s43, s49
  s_add_u32 s43, s43, 1835008
  s_cmp_lt_u32 s19, 512
  s_cselect_b32 s43, s43, 0x400000
  v_add_u32 v2, s43, v6
  v_add_u32 v3, s43, v6
  s_cmp_ge_u32 s74, 512
  s_cbranch_scc1 L_body2
  s_cmp_lg_u32 s73, 0
  s_cbranch_scc1 L_noatomic
  s_cmp_lt_u32 s74, 480
  s_cselect_b32 s75, 2, 1
  s_add_u32 s35, s75, s99
  s_mov_b32 s97, s35
  s_mov_b32 s99, 0
  s_atomic_add s35, s[36:37], 0 glc
L_noatomic:
  s_cmp_ge_u32 s74, 496
  s_cbranch_scc1 L_body2
  s_waitcnt vmcnt(9)
  v_dot2_f32_bf16 v40, v48, v8, 0
  v_dot2_f32_bf16 v40, v49, v9, v40
  v_dot2_f32_bf16 v40, v50, v10, v40
  v_dot2_f32_bf16 v40, v51, v11, v40
  buffer_load_dwordx4 v[48:51], v2, s[8:11], 0 offen nt
  s_waitcnt vmcnt(9)
  v_dot2_f32_bf16 v41, v52, v8, 0
  v_dot2_f32_bf16 v41, v53, v9, v41
  v_dot2_f32_bf16 v41, v54, v10, v41
  v_dot2_f32_bf16 v41, v55, v11, v41
  buffer_load_dwordx4 v[52:55], v2, s[8:11], s80 offen nt
  s_waitcnt vmcnt(9)
  v_dot2_f32_bf16 v42, v56, v8, 0
  v_dot2_f32_bf16 v42, v57, v9, v42
  v_dot2_f32_bf16 v42, v58, v10, v42
  v_dot2_f32_bf16 v42, v59, v11, v42
  buffer_load_dwordx4 v[56:59], v2, s[8:11], 0 offen offset:1024 nt
  s_waitcnt vmcnt(9)
  v_dot2_f32_bf16 v43, v60, v8, 0
  v_dot2_f32_bf16 v43, v61, v9, v43
  v_dot2_f32_bf16 v43, v62, v10, v43
  v_dot2_f32_bf16 v43, v63, v11, v43
  buffer_load_dwordx4 v[60:63], v2, s[8:11], s80 offen offset:1024 nt
  s_waitcnt vmcnt(9)
  v_dot2_f32_bf16 v44, v64, v8, 0
  v_dot2_f32_bf16 v44, v65, v9, v44
  v_dot2_f32_bf16 v44, v66, v10, v44
  v_dot2_f32_bf16 v44, v67, v11, v44
  buffer_load_dwordx4 v[64:67], v2, s[8:11], 0 offen offset:2048 nt
  s_waitcnt vmcnt(9)
  v_dot2_f32_bf16 v45, v68, v8, 0
  v_dot2_f32_bf16 v45, v69, v9, v45
  v_dot2_f32_bf16 v45, v70, v10, v45
  v_dot2_f32_bf16 v45, v71, v11, v45
  buffer_load_dwordx4 v[68:71], v2, s[8:11], s80 offen offset:2048 nt
  s_waitcnt vmcnt(9)
  v_dot2_f32_bf16 v46, v72, v8, 0
  v_dot2_f32_bf16 v46, v73, v9, v46
  v_dot2_f32_bf16 v46, v74, v10, v46
  v_dot2_f32_bf16 v46, v75, v11, v46
  buffer_load_dwordx4 v[72:75], v2, s[8:11], 0 offen offset:3072 nt
  s_waitcnt vmcnt(9)
  v_dot2_f32_bf16 v47, v76, v8, 0
  v_dot2_f32_bf16 v47, v77, v9, v47
  v_dot2_f32_bf16 v47, v78, v10, v47
  v_dot2_f32_bf16 v47, v79, v11, v47
  buffer_load_dwordx4 v[76:79], v2, s[8:11], s80 offen offset:3072 nt
  s_nop 1
  v_add_f32_dpp v112, v40, v40 row_ror:8 row_mask:0xf bank_mask:0x3
  v_add_f32_dpp v113, v42, v42 row_ror:8 row_mask:0xf bank_mask:0x3
  v_add_f32_dpp v114, v44, v44 row_ror:8 row_mask:0xf bank_mask:0x3
  v_add_f32_dpp v115, v46, v46 row_ror:8 row_mask:0xf bank_mask:0x3
  v_add_f32_dpp v112, v41, v41 row_ror:8 row_mask:0xf bank_mask:0xc
  v_add_f32_dpp v113, v43, v43 row_ror:8 row_mask:0xf bank_mask:0xc
  v_add_f32_dpp v114, v45, v45 row_ror:8 row_mask:0xf bank_mask:0xc
  v_add_f32_dpp v115, v47, v47 row_ror:8 row_mask:0xf bank_mask:0xc
  v_add_f32_dpp v112, v112, v112 row_half_mirror row_mask:0xf bank_mask:0xf
  v_add_f32_dpp v113, v113, v113 row_half_mirror row_mask:0xf bank_mask:0xf
  v_add_f32_dpp v114, v114, v114 row_half_mirror row_mask:0xf bank_mask:0xf
  v_add_f32_dpp v115, v115, v115 row_half_mirror row_mask:0xf bank_mask:0xf
  v_add_f32_dpp v112, v112, v112 quad_perm:[1,0,3,2] row_mask:0xf bank_mask:0xf
  v_add_f32_dpp v113, v113, v113 quad_perm:[1,0,3,2] row_mask:0xf bank_mask:0xf
  v_add_f32_dpp v114, v114, v114 quad_perm:[1,0,3,2] row_mask:0xf bank_mask:0xf
  v_add_f32_dpp v115, v115, v115 quad_perm:[1,0,3,2] row_mask:0xf bank_mask:0xf
  v_add_f32_dpp v112, v112, v112 quad_perm:[2,3,0,1] row_mask:0xf bank_mask:0xf
  v_add_f32_dpp v113, v113, v113 quad_perm:[2,3,0,1] row_mask:0xf bank_mask:0xf
  v_add_f32_dpp v114, v114, v114 quad_perm:[2,3,0,1] row_mask:0xf bank_mask:0xf
  v_add_f32_dpp v115, v115, v115 quad_perm:[2,3,0,1] row_mask:0xf bank_mask:0xf
  v_max3_f32 v35, v112, v113, v114
  v_max_f32 v35, v35, v115
  s_nop 1
  v_max_f32_dpp v35, v35, v35 row_ror:8 row_mask:0xf bank_mask:0xf
  s_nop 1
  v_max_f32_dpp v35, v35, v35 row_bcast:15 row_mask:0xa bank_mask:0xf
  s_nop 1
  v_max_f32_dpp v35, v35, v35 row_bcast:31 row_mask:0xc bank_mask:0xf
  v_mul_f32 v35, s18, v35
  s_nop 0
  v_readlane_b32 s19, v35, 63
  s_nop 1
  v_cmp_gt_f32 vcc, s19, v33
  s_cbranch_vccnz L_rescaleA
L_norescaleA:
  v_fma_f32 v112, v112, s18, -v33
  v_fma_f32 v113, v113, s18, -v33
  v_fma_f32 v114, v114, s18, -v33
  v_fma_f32 v115, v115, s18, -v33
  v_exp_f32 v112, v112
  v_exp_f32 v113, v113
  v_exp_f32 v114, v114
  v_exp_f32 v115, v115
  v_cvt_pk_bf16_f32 v112, v112, v112
  v_cvt_pk_bf16_f32 v113, v113, v113
  v_cvt_pk_bf16_f32 v114, v114, v114
  v_cvt_pk_bf16_f32 v115, v115, v115
  v_dot2_f32_bf16 v32, v112, v34, v32
  v_dot2_f32_bf16 v32, v113, v34, v32
  v_dot2_f32_bf16 v32, v114, v34, v32
  v_dot2_f32_bf16 v32, v115, v34, v32
  v_and_b32 v24, v112, v12
  v_and_b32 v25, v112, v13
  v_and_b32 v26, v112, v14
  v_and_b32 v27, v112, v15
  v_and_b32 v28, v112, v16
  v_and_b32 v29, v112, v17
  v_and_b32 v30, v112, v18
  v_and_b32 v31, v112, v19
  s_waitcnt vmcnt(9)
  v_mfma_f32_16x16x32_bf16 v[20:23], v[80:83], v[24:27], v[20:23]
  buffer_load_dwordx4 v[80:83], v3, s[12:15], 0 offen nt
  v_and_b32 v24, v113, v12
  v_and_b32 v25, v113, v13
  v_and_b32 v26, v113, v14
  v_and_b32 v27, v113, v15
  s_waitcnt vmcnt(9)
  v_mfma_f32_16x16x32_bf16 v[20:23], v[84:87], v[28:31], v[20:23]
  buffer_load_dwordx4 v[84:87], v3, s[12:15], s80 offen nt
  v_and_b32 v28, v113, v16
  v_and_b32 v29, v113, v17
  v_and_b32 v30, v113, v18
  v_and_b32 v31, v113, v19
  s_waitcnt vmcnt(9)
  v_mfma_f32_16x16x32_bf16 v[20:23], v[88:91], v[24:27], v[20:23]
  buffer_load_dwordx4 v[88:91], v3, s[12:15], 0 offen offset:1024 nt
  v_and_b32 v24, v114, v12
  v_and_b32 v25, v114, v13
  v_and_b32 v26, v114, v14
  v_and_b32 v27, v114, v15
  s_waitcnt vmcnt(9)
  v_mfma_f32_16x16x32_bf16 v[20:23], v[92:95], v[28:31], v[20:23]
  buffer_load_dwordx4 v[92:95], v3, s[12:15], s80 offen offset:1024 nt
  v_and_b32 v28, v114, v16
  v_and_b32 v29, v114, v17
  v_and_b32 v30, v114, v18
  v_and_b32 v31, v114, v19
  s_waitcnt vmcnt(9)
  v_mfma_f32_16x16x32_bf16 v[20:23], v[96:99], v[24:27], v[20:23]
  buffer_load_dwordx4 v[96:99], v3, s[12:15], 0 offen offset:2048 nt
  v_and_b32 v24, v115, v12
  v_and_b32 v25, v115, v13
  v_and_b32 v26, v115, v14
  v_and_b32 v27, v115, v15
  s_waitcnt vmcnt(9)
  v_mfma_f32_16x16x32_bf16 v[20:23], v[100:103], v[28:31], v[20:23]
  buffer_load_dwordx4 v[100:103], v3, s[12:15], s80 offen offset:2048 nt
  v_and_b32 v28, v115, v16
  v_and_b32 v29, v115, v17
  v_and_b32 v30, v115, v18
  v_and_b32 v31, v115, v19
  s_waitcnt vmcnt(9)
  v_mfma_f32_16x16x32_bf16 v[20:23], v[104:107], v[24:27], v[20:23]
  buffer_load_dwordx4 v[104:107], v3, s[12:15], 0 offen offset:3072 nt
  s_nop 1
  s_waitcnt vmcnt(9)
  v_mfma_f32_16x16x32_bf16 v[20:23], v[108:111], v[28:31], v[20:23]
  buffer_load_dwordx4 v[108:111], v3, s[12:15], s80 offen offset:3072 nt
  s_branch L_dyn
L_body2:
  s_waitcnt vmcnt(15)
  v_dot2_f32_bf16 v40, v48, v8, 0
  v_dot2_f32_bf16 v40, v49, v9, v40
  v_dot2_f32_bf16 v40, v50, v10, v40
  v_dot2_f32_bf16 v40, v51, v11, v40
  buffer_load_dwordx4 v[48:51], v2, s[8:11], 0 offen nt
  s_waitcnt vmcnt(15)
  v_dot2_f32_bf16 v41, v52, v8, 0
  v_dot2_f32_bf16 v41, v53, v9, v41
  v_dot2_f32_bf16 v41, v54, v10, v41
  v_dot2_f32_bf16 v41, v55, v11, v41
  buffer_load_dwordx4 v[52:55], v2, s[8:11], s80 offen nt
  s_waitcnt vmcnt(15)
  v_dot2_f32_bf16 v42, v56, v8, 0
  v_dot2_f32_bf16 v42, v57, v9, v42
  v_dot2_f32_bf16 v42, v58, v10, v42
  v_dot2_f32_bf16 v42, v59, v11, v42
  buffer_load_dwordx4 v[56:59], v2, s[8:11], 0 offen offset:1024 nt
  s_waitcnt vmcnt(15)
  v_dot2_f32_bf16 v43, v60, v8, 0
  v_dot2_f32_bf16 v43, v61, v9, v43
  v_dot2_f32_bf16 v43, v62, v10, v43
  v_dot2_f32_bf16 v43, v63, v11, v43
  buffer_load_dwordx4 v[60:63], v2, s[8:11], s80 offen offset:1024 nt
  s_waitcnt vmcnt(15)
  v_dot2_f32_bf16 v44, v64, v8, 0
  v_dot2_f32_bf16 v44, v65, v9, v44
  v_dot2_f32_bf16 v44, v66, v10, v44
  v_dot2_f32_bf16 v44, v67, v11, v44
  buffer_load_dwordx4 v[64:67], v2, s[8:11], 0 offen offset:2048 nt
  s_waitcnt vmcnt(15)
  v_dot2_f32_bf16 v45, v68, v8, 0
  v_dot2_f32_bf16 v45, v69, v9, v45
  v_dot2_f32_bf16 v45, v70, v10, v45
  v_dot2_f32_bf16 v45, v71, v11, v45
  buffer_load_dwordx4 v[68:71], v2, s[8:11], s80 offen offset:2048 nt
  s_waitcnt vmcnt(15)
  v_dot2_f32_bf16 v46, v72, v8, 0
  v_dot2_f32_bf16 v46, v73, v9, v46
  v_dot2_f32_bf16 v46, v74, v10, v46
  v_dot2_f32_bf16 v46, v75, v11, v46
  buffer_load_dwordx4 v[72:75], v2, s[8:11], 0 offen offset:3072 nt
  s_waitcnt vmcnt(15)
  v_dot2_f32_bf16 v47, v76, v8, 0
  v_dot2_f32_bf16 v47, v77, v9, v47
  v_dot2_f32_bf16 v47, v78, v10, v47
  v_dot2_f32_bf16 v47, v79, v11, v47
  buffer_load_dwordx4 v[76:79], v2, s[8:11], s80 offen offset:3072 nt
  s_nop 1
  v_add_f32_dpp v112, v40, v40 row_ror:8 row_mask:0xf bank_mask:0x3
  v_add_f32_dpp v113, v42, v42 row_ror:8 row_mask:0xf bank_mask:0x3
  v_add_f32_dpp v114, v44, v44 row_ror:8 row_mask:0xf bank_mask:0x3
  v_add_f32_dpp v115, v46, v46 row_ror:8 row_mask:0xf bank_mask:0x3
  v_add_f32_dpp v112, v41, v41 row_ror:8 row_mask:0xf bank_mask:0xc
  v_add_f32_dpp v113, v43, v43 row_ror:8 row_mask:0xf bank_mask:0xc
  v_add_f32_dpp v114, v45, v45 row_ror:8 row_mask:0xf bank_mask:0xc
  v_add_f32_dpp v115, v47, v47 row_ror:8 row_mask:0xf bank_mask:0xc
  v_add_f32_dpp v112, v112, v112 row_half_mirror row_mask:0xf bank_mask:0xf
  v_add_f32_dpp v113, v113, v113 row_half_mirror row_mask:0xf bank_mask:0xf
  v_add_f32_dpp v114, v114, v114 row_half_mirror row_mask:0xf bank_mask:0xf
  v_add_f32_dpp v115, v115, v115 row_half_mirror row_mask:0xf bank_mask:0xf
  v_add_f32_dpp v112, v112, v112 quad_perm:[1,0,3,2] row_mask:0xf bank_mask:0xf
  v_add_f32_dpp v113, v113, v113 quad_perm:[1,0,3,2] row_mask:0xf bank_mask:0xf
  v_add_f32_dpp v114, v114, v114 quad_perm:[1,0,3,2] row_mask:0xf bank_mask:0xf
  v_add_f32_dpp v115, v115, v115 quad_perm:[1,0,3,2] row_mask:0xf bank_mask:0xf
  v_add_f32_dpp v112, v112, v112 quad_perm:[2,3,0,1] row_mask:0xf bank_mask:0xf
  v_add_f32_dpp v113, v113, v113 quad_perm:[2,3,0,1] row_mask:0xf bank_mask:0xf
  v_add_f32_dpp v114, v114, v114 quad_perm:[2,3,0,1] row_mask:0xf bank_mask:0xf
  v_add_f32_dpp v115, v115, v115 quad_perm:[2,3,0,1] row_mask:0xf bank_mask:0xf
  v_max3_f32 v35, v112, v113, v114
  v_max_f32 v35, v35, v115
  s_nop 1
  v_max_f32_dpp v35, v35, v35 row_ror:8 row_mask:0xf bank_mask:0xf
  s_nop 1
  v_max_f32_dpp v35, v35, v35 row_bcast:15 row_mask:0xa bank_mask:0xf
  s_nop 1
  v_max_f32_dpp v35, v35, v35 row_bcast:31 row_mask:0xc bank_mask:0xf
  v_mul_f32 v35, s18, v35
  s_nop 0
  v_readlane_b32 s19, v35, 63
  s_nop 1
  v_cmp_gt_f32 vcc, s19, v33
  s_cbranch_vccnz L_rescaleB
L_norescaleB:
  v_fma_f32 v112, v112, s18, -v33
  v_fma_f32 v113, v113, s18, -v33
  v_fma_f32 v114, v114, s18, -v33
  v_fma_f32 v115, v115, s18, -v33
  v_exp_f32 v112, v112
  v_exp_f32 v113, v113
  v_exp_f32 v114, v114
  v_exp_f32 v115, v115
  v_cvt_pk_bf16_f32 v112, v112, v112
  v_cvt_pk_bf16_f32 v113, v113, v113
  v_cvt_pk_bf16_f32 v114, v114, v114
  v_cvt_pk_bf16_f32 v115, v115, v115
  v_dot2_f32_bf16 v32, v112, v34, v32
  v_dot2_f32_bf16 v32, v113, v34, v32
  v_dot2_f32_bf16 v32, v114, v34, v32
  v_dot2_f32_bf16 v32, v115, v34, v32
  v_and_b32 v24, v112, v12
  v_and_b32 v25, v112, v13
  v_and_b32 v26, v112, v14
  v_and_b32 v27, v112, v15
  v_and_b32 v28, v112, v16
  v_and_b32 v29, v112, v17
  v_and_b32 v30, v112, v18
  v_and_b32 v31, v112, v19
  s_waitcnt vmcnt(15)
  v_mfma_f32_16x16x32_bf16 v[20:23], v[80:83], v[24:27], v[20:23]
  buffer_load_dwordx4 v[80:83], v3, s[12:15], 0 offen nt
  v_and_b32 v24, v113, v12
  v_and_b32 v25, v113, v13
  v_and_b32 v26, v113, v14
  v_and_b32 v27, v113, v15
  s_waitcnt vmcnt(15)
  v_mfma_f32_16x16x32_bf16 v[20:23], v[84:87], v[28:31], v[20:23]
  buffer_load_dwordx4 v[84:87], v3, s[12:15], s80 offen nt
  v_and_b32 v28, v113, v16
  v_and_b32 v29, v113, v17
  v_and_b32 v30, v113, v18
  v_and_b32 v31, v113, v19
  s_waitcnt vmcnt(15)
  v_mfma_f32_16x16x32_bf16 v[20:23], v[88:91], v[24:27], v[20:23]
  buffer_load_dwordx4 v[88:91], v3, s[12:15], 0 offen offset:1024 nt
  v_and_b32 v24, v114, v12
  v_and_b32 v25, v114, v13
  v_and_b32 v26, v114, v14
  v_and_b32 v27, v114, v15
  s_waitcnt vmcnt(15)
  v_mfma_f32_16x16x32_bf16 v[20:23], v[92:95], v[28:31], v[20:23]
  buffer_load_dwordx4 v[92:95], v3, s[12:15], s80 offen offset:1024 nt
  v_and_b32 v28, v114, v16
  v_and_b32 v29, v114, v17
  v_and_b32 v30, v114, v18
  v_and_b32 v31, v114, v19
  s_waitcnt vmcnt(15)
  v_mfma_f32_16x16x32_bf16 v[20:23], v[96:99], v[24:27], v[20:23]
  buffer_load_dwordx4 v[96:99], v3, s[12:15], 0 offen offset:2048 nt
  v_and_b32 v24, v115, v12
  v_and_b32 v25, v115, v13
  v_and_b32 v26, v115, v14
  v_and_b32 v27, v115, v15
  s_waitcnt vmcnt(15)
  v_mfma_f32_16x16x32_bf16 v[20:23], v[100:103], v[28:31], v[20:23]
  buffer_load_dwordx4 v[100:103], v3, s[12:15], s80 offen offset:2048 nt
  v_and_b32 v28, v115, v16
  v_and_b32 v29, v115, v17
  v_and_b32 v30, v115, v18
  v_and_b32 v31, v115, v19
  s_waitcnt vmcnt(15)
  v_mfma_f32_16x16x32_bf16 v[20:23], v[104:107], v[24:27], v[20:23]
  buffer_load_dwordx4 v[104:107], v3, s[12:15], 0 offen offset:3072 nt
  s_nop 1
  s_waitcnt vmcnt(15)
  v_mfma_f32_16x16x32_bf16 v[20:23], v[108:111], v[28:31], v[20:23]
  buffer_load_dwordx4 v[108:111], v3, s[12:15], s80 offen offset:3072 nt
  s_cmp_lt_u32 s74, 512
  s_cbranch_scc1 L_dyn
  v_add_f32_dpp v32, v32, v32 row_ror:8 row_mask:0xf bank_mask:0xf
  s_mov_b32 s33, 1
  s_atomic_add s33, s[36:37], 4 glc
  v_add_f32_dpp v32, v32, v32 row_bcast:15 row_mask:0xa bank_mask:0xf
  s_cmp_ge_u32 s96, 516
  s_cselect_b32 s98, s98, 0
  s_cbranch_scc0 L_nospec
  buffer_load_dwordx4 v[124:127], v5, s[64:67], s89 offen sc0 sc1
  buffer_load_dwordx4 v[128:131], v5, s[64:67], s90 offen sc0 sc1
  buffer_load_dwordx4 v[132:135], v5, s[64:67], s91 offen sc0 sc1
  buffer_load_dwordx4 v[136:139], v5, s[64:67], s92 offen sc0 sc1
  buffer_load_dwordx4 v[140:143], v5, s[64:67], s93 offen sc0 sc1
  buffer_load_dwordx4 v[144:147], v5, s[64:67], s94 offen sc0 sc1
  buffer_load_dwordx4 v[148:151], v5, s[64:67], s95 offen sc0 sc1
L_nospec:
  v_add_f32_dpp v32, v32, v32 row_bcast:31 row_mask:0xc bank_mask:0xf
  v_add_f32_dpp v20, v20, v20 row_ror:8 row_mask:0xf bank_mask:0xf
  v_add_f32_dpp v21, v21, v21 row_ror:8 row_mask:0xf bank_mask:0xf
  v_add_f32_dpp v22, v22, v22 row_ror:8 row_mask:0xf bank_mask:0xf
  v_add_f32_dpp v23, v23, v23 row_ror:8 row_mask:0xf bank_mask:0xf
  v_readlane_b32 s30, v32, 63
  v_cndmask_b32 v20, v20, v33, s[86:87]
  s_nop 0
  v_mov_b32 v35, s30
  v_cndmask_b32 v21, v21, v35, s[86:87]
  v_min_u32 v20, 0xfffffffe, v20
  v_min_u32 v21, 0xfffffffe, v21
  v_min_u32 v22, 0xfffffffe, v22
  v_min_u32 v23, 0xfffffffe, v23
  buffer_store_dwordx4 v[20:23], v5, s[64:67], s88 offen sc0 sc1
  s_waitcnt lgkmcnt(0)
  s_cmp_eq_u32 s33, 7
  s_cbranch_scc1 L_last
L_done:
  s_endpgm
L_last:
  s_cmp_eq_u32 s98, 8
  s_cbranch_scc1 L_spec_ok
L_reload:
  buffer_load_dwordx4 v[124:127], v5, s[64:67], s89 offen sc0 sc1
  buffer_load_dwordx4 v[128:131], v5, s[64:67], s90 offen sc0 sc1
  buffer_load_dwordx4 v[132:135], v5, s[64:67], s91 offen sc0 sc1
  buffer_load_dwordx4 v[136:139], v5, s[64:67], s92 offen sc0 sc1
  buffer_load_dwordx4 v[140:143], v5, s[64:67], s93 offen sc0 sc1
  buffer_load_dwordx4 v[144:147], v5, s[64:67], s94 offen sc0 sc1
  buffer_load_dwordx4 v[148:151], v5, s[64:67], s95 offen sc0 sc1
  s_waitcnt vmcnt(0)
L_spec_ok:
  s_waitcnt vmcnt(1)
  v_max3_u32 v152, v124, v125, v126
  v_max3_u32 v152, v152, v127, v128
  v_max3_u32 v152, v152, v129, v130
  v_max3_u32 v152, v152, v131, v132
  v_max3_u32 v152, v152, v133, v134
  v_max3_u32 v152, v152, v135, v136
  v_max3_u32 v152, v152, v137, v138
  v_max3_u32 v152, v152, v139, v140
  v_max3_u32 v152, v152, v141, v142
  v_max3_u32 v152, v152, v143, v144
  v_max3_u32 v152, v152, v145, v146
  v_max3_u32 v152, v152, v147, v148
  v_max3_u32 v152, v152, v149, v150
  v_max_u32 v152, v152, v151
  v_cmp_eq_u32 vcc, -1, v152
  s_cbranch_vccnz L_reload
  v_max3_f32 v152, v20, v124, v128
  v_max3_f32 v152, v152, v132, v136
  v_max3_f32 v152, v152, v140, v144
  v_max_f32 v152, v152, v148
  v_sub_f32 v153, v20, v152
  v_sub_f32 v154, v124, v152
  v_sub_f32 v155, v128, v152
  v_sub_f32 v156, v132, v152
  v_sub_f32 v157, v136, v152
  v_sub_f32 v158, v140, v152
  v_sub_f32 v159, v144, v152
  v_sub_f32 v160, v148, v152
  v_exp_f32 v153, v153
  v_exp_f32 v154, v154
  v_exp_f32 v155, v155
  v_exp_f32 v156, v156
  v_exp_f32 v157, v157
  v_exp_f32 v158, v158
  v_exp_f32 v159, v159
  v_exp_f32 v160, v160
  s_nop 0
  v_mul_f32 v152, v153, v21
  v_fmac_f32 v152, v154, v125
  v_fmac_f32 v152, v155, v129
  v_fmac_f32 v152, v156, v133
  v_fmac_f32 v152, v157, v137
  v_fmac_f32 v152, v158, v141
  v_fmac_f32 v152, v159, v145
  v_fmac_f32 v152, v160, v149
  v_rcp_f32 v152, v152
  s_nop 0
  v_mul_f32 v153, v153, v152
  v_mul_f32 v154, v154, v152
  v_mul_f32 v155, v155, v152
  v_mul_f32 v156, v156, v152
  v_mul_f32 v157, v157, v152
  v_mul_f32 v158, v158, v152
  v_mul_f32 v159, v159, v152
  v_mul_f32 v160, v160, v152
  v_mul_f32_dpp v40, v153, v20 row_ror:8 row_mask:0xf bank_mask:0xf
  v_mul_f32_dpp v41, v153, v21 row_ror:8 row_mask:0xf bank_mask:0xf
  v_mul_f32_dpp v42, v153, v22 row_ror:8 row_mask:0xf bank_mask:0xf
  v_mul_f32_dpp v43, v153, v23 row_ror:8 row_mask:0xf bank_mask:0xf
  v_fmac_f32_dpp v40, v154, v124 row_ror:8 row_mask:0xf bank_mask:0xf
  v_fmac_f32_dpp v41, v154, v125 row_ror:8 row_mask:0xf bank_mask:0xf
  v_fmac_f32_dpp v42, v154, v126 row_ror:8 row_mask:0xf bank_mask:0xf
  v_fmac_f32_dpp v43, v154, v127 row_ror:8 row_mask:0xf bank_mask:0xf
  v_fmac_f32_dpp v40, v155, v128 row_ror:8 row_mask:0xf bank_mask:0xf
  v_fmac_f32_dpp v41, v155, v129 row_ror:8 row_mask:0xf bank_mask:0xf
  v_fmac_f32_dpp v42, v155, v130 row_ror:8 row_mask:0xf bank_mask:0xf
  v_fmac_f32_dpp v43, v155, v131 row_ror:8 row_mask:0xf bank_mask:0xf
  v_fmac_f32_dpp v40, v156, v132 row_ror:8 row_mask:0xf bank_mask:0xf
  v_fmac_f32_dpp v41, v156, v133 row_ror:8 row_mask:0xf bank_mask:0xf
  v_fmac_f32_dpp v42, v156, v134 row_ror:8 row_mask:0xf bank_mask:0xf
  v_fmac_f32_dpp v43, v156, v135 row_ror:8 row_mask:0xf bank_mask:0xf
  v_fmac_f32_dpp v40, v157, v136 row_ror:8 row_mask:0xf bank_mask:0xf
  v_fmac_f32_dpp v41, v157, v137 row_ror:8 row_mask:0xf bank_mask:0xf
  v_fmac_f32_dpp v42, v157, v138 row_ror:8 row_mask:0xf bank_mask:0xf
  v_fmac_f32_dpp v43, v157, v139 row_ror:8 row_mask:0xf bank_mask:0xf
  v_fmac_f32_dpp v40, v158, v140 row_ror:8 row_mask:0xf bank_mask:0xf
  v_fmac_f32_dpp v41, v158, v141 row_ror:8 row_mask:0xf bank_mask:0xf
  v_fmac_f32_dpp v42, v158, v142 row_ror:8 row_mask:0xf bank_mask:0xf
  v_fmac_f32_dpp v43, v158, v143 row_ror:8 row_mask:0xf bank_mask:0xf
  v_fmac_f32_dpp v40, v159, v144 row_ror:8 row_mask:0xf bank_mask:0xf
  v_fmac_f32_dpp v41, v159, v145 row_ror:8 row_mask:0xf bank_mask:0xf
  v_fmac_f32_dpp v42, v159, v146 row_ror:8 row_mask:0xf bank_mask:0xf
  v_fmac_f32_dpp v43, v159, v147 row_ror:8 row_mask:0xf bank_mask:0xf
  v_fmac_f32_dpp v40, v160, v148 row_ror:8 row_mask:0xf bank_mask:0xf
  v_fmac_f32_dpp v41, v160, v149 row_ror:8 row_mask:0xf bank_mask:0xf
  v_fmac_f32_dpp v42, v160, v150 row_ror:8 row_mask:0xf bank_mask:0xf
  v_fmac_f32_dpp v43, v160, v151 row_ror:8 row_mask:0xf bank_mask:0xf
  v_cvt_pk_bf16_f32 v40, v40, v41
  v_cvt_pk_bf16_f32 v42, v42, v43
  s_lshl_b32 s31, s28, 8
  buffer_store_short v40, v120, s[68:71], s31 offen
  buffer_store_short_d16_hi v40, v120, s[68:71], s31 offen offset:16
  buffer_store_short v42, v120, s[68:71], s31 offen offset:32
  buffer_store_short_d16_hi v42, v120, s[68:71], s31 offen offset:48
  s_endpgm
L_rescaleA:
  v_subrev_f32 v36, s19, v33
  v_exp_f32 v36, v36
  v_mov_b32 v33, s19
  v_mul_f32 v20, v20, v36
  v_mul_f32 v21, v21, v36
  v_mul_f32 v22, v22, v36
  v_mul_f32 v23, v23, v36
  v_mul_f32 v32, v32, v36
  s_branch L_norescaleA
L_rescaleB:
  v_subrev_f32 v36, s19, v33
  v_exp_f32 v36, v36
  v_mov_b32 v33, s19
  v_mul_f32 v20, v20, v36
  v_mul_f32 v21, v21, v36
  v_mul_f32 v22, v22, v36
  v_mul_f32 v23, v23, v36
  v_mul_f32 v32, v32, v36
  s_branch L_norescaleB
L_ev_flagload:
  s_waitcnt lgkmcnt(0)
  s_load_dword s35, s[40:41], 0
  s_branch L_kbody
L_ev_klast:
  s_waitcnt lgkmcnt(0)
  s_cmp_lg_u32 s35, 0
  s_cbranch_scc1 L_flagok
  s_sleep 4
  s_atomic_add s35, s[40:41], 0 glc
  s_branch L_ev_klast
L_flagok:
  ds_read_b32 v122, v121
  s_waitcnt lgkmcnt(0)
  v_readfirstlane_b32 s30, v122
  s_cmp_eq_u32 s30, 0x5a5a1234
  s_cbranch_scc0 L_flagok
  s_mov_b32 s8, s78
  s_mov_b32 s9, s79
  s_mov_b32 s12, s78
  s_mov_b32 s13, s79
  s_lshl_b32 s16, s34, 14
  s_branch L_kbody
L_ev_vlast:
  s_mov_b32 s8, s76
  s_mov_b32 s9, s77
  s_mul_i32 s19, s34, 2
  s_add_u32 s19, s19, 448
  s_mov_b32 s74, s19
  s_mov_b32 s73, 1
  s_sub_u32 s48, s19, 448
  s_and_b32 s49, s48, 1
  s_lshl_b32 s49, s49, 21
  s_lshr_b32 s43, s48, 2
  s_lshl_b32 s43, s43, 14
  s_or_b32 s43, s43, s49
  s_bfe_u32 s49, s48, 0x10001
  s_lshl_b32 s49, s49, 12
  s_or_b32 s43, s43, s49
  s_add_u32 s43, s43, 1835008
  s_cmp_lt_u32 s19, 512
  s_cselect_b32 s43, s43, 0x400000
  v_add_u32 v2, s43, v6
  v_add_u32 v3, s43, v6
  s_branch L_vbody
L_helper:
  s_mov_b32 s86, 0xff00ff00
  s_mov_b32 s87, 0xff00ff00
  v_lshrrev_b32 v37, 4, v1
  v_lshl_add_u32 v5, v37, 3, v35
  v_lshlrev_b32 v5, 4, v5
  v_mov_b32 v36, 0x200
  v_cndmask_b32 v5, v5, v36, s[86:87]
  v_mov_b32 v124, -1
  v_mov_b32 v125, -1
  v_mov_b32 v126, -1
  v_mov_b32 v127, -1
  s_lshl_b32 s30, s28, 13
  s_lshl_b32 s31, s34, 10
  s_add_u32 s33, s31, 0x2000
  s_waitcnt lgkmcnt(0)
  s_add_u32 s64, s46, s30
  s_addc_u32 s65, s47, 0
  s_mov_b32 s66, 0x4000
  s_mov_b32 s67, 0x20000
  buffer_store_dwordx4 v[124:127], v5, s[64:67], s31 offen sc0 sc1
  buffer_store_dwordx4 v[124:127], v5, s[64:67], s33 offen sc0 sc1
  s_barrier
  s_cmp_lg_u32 s34, 1
  s_cbranch_scc1 L_hnoinit
  s_lshl_b32 s30, s28, 8
  s_add_u32 s30, s30, 0x100000
  s_add_u32 s36, s46, s30
  s_addc_u32 s37, s47, 0
  s_lshl_b32 s30, s28, 2
  s_add_u32 s40, s44, s30
  s_addc_u32 s41, s45, 0
  s_mov_b64 s[38:39], 0
  s_mov_b64 s[48:49], 0
  s_atomic_swap_x2 s[38:39], s[36:37], 0 glc
  s_atomic_swap_x2 s[48:49], s[36:37], 0x100 glc
  s_waitcnt lgkmcnt(0)
  s_mov_b32 s38, 1
  s_mov_b32 s39, 1
  s_atomic_add_x2 s[38:39], s[40:41], 0
L_hnoinit:
  v_mov_b32 v121, 16384
  v_mov_b32 v122, 0x5a5a1234
  s_waitcnt vmcnt(0)
  ds_write_b32 v121, v122
  s_waitcnt lgkmcnt(0)
  s_endpgm
.section .rodata,"a"
.p2align 6
.amdhsa_kernel standalone__softmax_full_bidir__decode_kernel
  .amdhsa_next_free_vgpr 164
  .amdhsa_next_free_sgpr 100
  .amdhsa_accum_offset 164
  .amdhsa_group_segment_fixed_size 0
  .amdhsa_kernarg_size 48
  .amdhsa_user_sgpr_count 2
  .amdhsa_user_sgpr_kernarg_segment_ptr 1
  .amdhsa_system_sgpr_workgroup_id_x 1
.end_amdhsa_kernel
```
